```python
import torch

def _softmax(x, axis=-1):
    return torch.softmax(x, dim=axis)
def _gelu(x):
    return torch.nn.functional.gelu(x, approximate="tanh")
def _silu(x):
    return torch.nn.functional.silu(x)
def _sigmoid(x):
    return torch.sigmoid(x)
def _layernorm(x, axis=-1, eps=1e-5):
    m = x.mean(dim=axis, keepdim=True)
    v = x.var(dim=axis, keepdim=True, unbiased=False)
    return (x - m) / torch.sqrt(v + eps)
def _scatter_add(tgt, idx, src, axis=0):
    return tgt.clone().index_add_(axis, idx, src)
def _segment_sum(src, seg, n):
    out = torch.zeros((n,) + src.shape[1:], dtype=src.dtype)
    return out.index_add_(0, seg, src)
def _pad(x, pw):
    flat = tuple(v for pair in reversed(pw) for v in pair)
    return torch.nn.functional.pad(x, flat)

kernel_name = 'standalone__swiglu_ffn__sampling'

def setup_inputs():

    _w = (lambda a: (lambda t: t.to(torch.bfloat16) if t.is_floating_point() else t)(torch.as_tensor(a)))
    B, S, D, F = 8, 16, 1024, 3584
    return {
        "x": _w((lambda *s: torch.randn(*s, dtype=torch.bfloat16) * 0.05)(B, S, D)),
        "w_gate": _w((lambda *s: torch.randn(*s, dtype=torch.bfloat16) * 0.05)(D, F)),
        "w_up": _w((lambda *s: torch.randn(*s, dtype=torch.bfloat16) * 0.05)(D, F)),
        "w_down": _w((lambda *s: torch.randn(*s, dtype=torch.bfloat16) * 0.05)(F, D)),
    }

def reference(x, w_gate, w_up, w_down):
    g = _silu(x @ w_gate)
    u = x @ w_up
    return (g * u) @ w_down
```

```asm
; @launch grid=(256,1,1) block=(512,1,1) lds=163840
.amdgcn_target "amdgcn-amd-amdhsa--gfx950"
.text
.p2align 12
.fill 832, 4, 0xbf810000
.globl standalone__swiglu_ffn__sampling_kernel
.p2align 8
.type standalone__swiglu_ffn__sampling_kernel,@function
standalone__swiglu_ffn__sampling_kernel:
    s_memrealtime s[56:57]
    s_load_dwordx2 s[24:25], s[0:1], 8
    s_load_dwordx2 s[28:29], s[0:1], 16
    s_load_dwordx2 s[20:21], s[0:1], 0
    s_load_dwordx2 s[36:37], s[0:1], 24
    s_load_dwordx2 s[40:41], s[0:1], 32
    s_load_dwordx2 s[44:45], s[0:1], 40
    s_load_dwordx2 s[32:33], s[0:1], 48
    s_lshr_b32 s15, s2, 3
    s_cmp_ge_u32 s15, 32
    s_cbranch_scc1 DONE
    s_getpc_b64 s[4:5]
PCREF:
    v_lshlrev_b32 v2, 7, v0
    v_min_u32 v2, (CODE_END-PCREF-4), v2
    v_lshrrev_b32 v1, 6, v0
    global_load_dword v255, v2, s[4:5]
    v_readfirstlane_b32 s17, v1
    v_and_b32 v0, 63, v0
    s_and_b32 s14, s2, 7
    s_mov_b32 s23, 0x20000
    s_mov_b32 s22, 262144
    s_mov_b32 s26, 7340032
    s_mov_b32 s27, 0x20000
    s_mov_b32 s30, s26
    s_mov_b32 s31, 0x20000
    v_lshrrev_b32 v10, 3, v0
    v_and_b32 v11, 7, v0
    v_lshrrev_b32 v12, 4, v0
    s_cmp_ge_u32 s15, 14
    s_cbranch_scc1 HELPER
    s_mul_i32 s12, s14, 7
    s_lshr_b32 s11, s15, 1
    s_add_u32 s12, s12, s11
    s_and_b32 s13, s15, 1
    s_mov_b32 s10, s13
    s_cmp_lt_u32 s17, 4
    s_cbranch_scc1 W_COMPUTE
    s_sub_u32 s16, s17, 4
    s_mul_i32 s46, s16, 114688
    s_lshl_b32 s47, s12, 7
    s_add_u32 s46, s46, s47
    v_and_b32 v13, 1, v12
    v_lshlrev_b32 v13, 2, v13
    v_xor_b32 v13, v13, v11
    v_lshlrev_b32 v13, 4, v13
    v_mul_u32_u24 v14, 7168, v10
    v_add3_u32 v2, v13, v14, s46
    v_add_u32 v3, 56320, v2
    s_lshl_b32 s46, s13, 17
    s_lshl_b32 s47, s16, 15
    s_add_u32 s46, s46, s47
    v_xor_b32 v13, v12, v11
    v_lshlrev_b32 v13, 4, v13
    v_lshlrev_b32 v14, 11, v10
    v_add3_u32 v4, v13, v14, s46
    v_xor_b32 v5, 64, v4
    v_add_u32 v5, 15360, v5
    s_lshl_b32 s46, s16, 11
    s_mov_b32 s50, 0
    s_add_u32 s51, s46, 8192
    s_mov_b32 s48, 0
    s_mov_b32 s53, s51
    s_waitcnt lgkmcnt(0)
L_PRO:
    s_mov_b32 m0, s51
    s_lshl_b32 s49, s50, 7
    buffer_load_dwordx4 v2, s[24:27], s48 offen lds
    buffer_load_dwordx4 v3, s[24:27], s48 offen offset:1024 lds
    s_add_u32 m0, s51, 8192
    s_add_u32 s50, s50, 1
    buffer_load_dwordx4 v2, s[28:31], s48 offen lds
    buffer_load_dwordx4 v3, s[28:31], s48 offen offset:1024 lds
    s_sub_u32 m0, s51, 8192
    s_and_b32 s52, s50, 3
    buffer_load_dwordx4 v4, s[20:23], s49 offen lds
    buffer_load_dwordx4 v5, s[20:23], s49 offen offset:1024 lds
    s_mul_i32 s52, s52, 24576
    s_add_u32 s51, s52, s53
    s_add_u32 s48, s48, 458752
    s_mov_b32 m0, s51
    s_lshl_b32 s49, s50, 7
    buffer_load_dwordx4 v2, s[24:27], s48 offen lds
    buffer_load_dwordx4 v3, s[24:27], s48 offen offset:1024 lds
    s_branch L_SETUP
HELPER:
    s_sub_u32 s16, s15, 14
    s_cmp_lg_u32 s17, 0
    s_cbranch_scc1 H_WD
    s_cmp_ge_u32 s16, 16
    s_cbranch_scc1 H_X
    v_min_u32 v13, 6, v11
    v_lshlrev_b32 v13, 7, v13
    v_mul_u32_u24 v14, 7168, v10
    s_mul_i32 s47, s14, 896
    s_lshr_b32 s48, s16, 1
    s_mul_i32 s48, s48, 57344
    s_add_u32 s47, s47, s48
    v_add3_u32 v13, v13, v14, s47
    s_mov_b32 s49, 458752
    s_bitcmp1_b32 s16, 0
    s_waitcnt lgkmcnt(0)
    s_mov_b64 s[86:87], s[24:25]
    s_cselect_b32 s24, s28, s24
    s_cselect_b32 s25, s29, s25
    s_branch H_GO
H_X:
    s_and_b32 s47, s16, 1
    s_lshl_b32 s47, s47, 17
    v_lshlrev_b32 v13, 11, v0
    v_add_u32 v13, s47, v13
    s_mov_b32 s49, 128
    s_mov_b32 s26, s22
    s_waitcnt lgkmcnt(0)
    s_mov_b64 s[86:87], s[24:25]
    s_mov_b32 s24, s20
    s_mov_b32 s25, s21
H_GO:
    s_mov_b32 s48, 0
    v_min_u32 v14, 6, v11
    v_lshlrev_b32 v14, 20, v14
    global_load_dword v17, v14, s[86:87]
    global_load_dword v17, v14, s[28:29]
    global_load_dword v17, v14, s[36:37]
    buffer_load_dword v16, v13, s[24:27], s48 offen
    s_add_u32 s48, s48, s49
    buffer_load_dword v16, v13, s[24:27], s48 offen
    s_add_u32 s48, s48, s49
    buffer_load_dword v16, v13, s[24:27], s48 offen
    s_add_u32 s48, s48, s49
    buffer_load_dword v16, v13, s[24:27], s48 offen
    s_add_u32 s48, s48, s49
    buffer_load_dword v16, v13, s[24:27], s48 offen
    s_add_u32 s48, s48, s49
    s_cmp_lg_u32 s16, 17
    s_cbranch_scc1 H_NF
    s_mul_i32 s46, s14, 7168
    s_add_u32 s46, s46, 1114112
    v_min_u32 v15, 55, v0
    v_lshl_add_u32 v15, v15, 7, s46
    global_load_dword v17, v15, s[32:33]
H_NF:
    buffer_load_dword v16, v13, s[24:27], s48 offen
    s_add_u32 s48, s48, s49
    buffer_load_dword v16, v13, s[24:27], s48 offen
    s_add_u32 s48, s48, s49
    buffer_load_dword v16, v13, s[24:27], s48 offen
    s_add_u32 s48, s48, s49
    buffer_load_dword v16, v13, s[24:27], s48 offen
    s_add_u32 s48, s48, s49
    buffer_load_dword v16, v13, s[24:27], s48 offen
    s_add_u32 s48, s48, s49
    buffer_load_dword v16, v13, s[24:27], s48 offen
    s_add_u32 s48, s48, s49
    buffer_load_dword v16, v13, s[24:27], s48 offen
    s_add_u32 s48, s48, s49
    buffer_load_dword v16, v13, s[24:27], s48 offen
    s_add_u32 s48, s48, s49
    buffer_load_dword v16, v13, s[24:27], s48 offen
    s_add_u32 s48, s48, s49
    buffer_load_dword v16, v13, s[24:27], s48 offen
    s_add_u32 s48, s48, s49
    buffer_load_dword v16, v13, s[24:27], s48 offen
    s_branch H_WD
DONE:
    s_endpgm
P2SETUP:
    s_mov_b32 s8, 0
    s_mov_b32 s54, 0
    s_mov_b32 s34, 6291456
    s_mov_b32 s35, 0x20000
    s_mov_b32 s38, 7340032
    s_mov_b32 s39, 0x20000
    s_mov_b32 s42, 262144
    s_mov_b32 s43, 0x20000
    s_movk_i32 s95, 0xfff
    v_lshlrev_b32 v240, 4, v0
    v_mov_b32 v249, 0
    s_lshl_b32 s46, s14, 2
    s_add_u32 s46, s46, s10
    s_mul_i32 s46, s46, 1792
    s_add_u32 s80, s46, 1048576
    s_lshl_b32 s47, s17, 2
    v_and_b32 v246, 3, v0
    v_add_u32 v246, s47, v246
    v_min_u32 v246, 13, v246
    v_lshlrev_b32 v246, 7, v246
    v_bfe_u32 v251, v0, 2, 1
    v_lshl_add_u32 v254, v251, 16, v246
    v_add_u32 v246, 65536, v246
    s_mul_i32 s46, s10, 224
    s_add_u32 s47, s46, s47
    s_mul_i32 s46, s14, 14
    s_add_u32 s46, s46, s47
    s_lshl_b32 s46, s46, 10
    s_add_u32 s81, s46, 65536
    s_add_u32 s82, s81, 113664
    s_sub_u32 s83, s81, 1024
    s_sub_u32 s84, s82, 1024
    s_lshl_b32 s46, s17, 13
    s_add_u32 s85, s46, 49152
    v_bfe_u32 v251, v0, 2, 3
    v_lshrrev_b32 v252, 5, v0
    v_lshl_add_u32 v252, v252, 4, v251
    v_lshlrev_b32 v252, 8, v252
    s_and_b32 s46, s17, 6
    v_xor_b32 v251, s46, v251
    v_lshl_add_u32 v252, v251, 5, v252
    v_and_b32 v251, 3, v0
    v_lshl_add_u32 v244, v251, 3, v252
    v_add_u32 v242, 98304, v244
    v_xor_b32 v245, 32, v244
    v_xor_b32 v243, 32, v242
    s_and_b32 s46, s17, 1
    s_lshl_b32 s46, s46, 10
    s_add_u32 s46, s46, 49152
    v_add_u32 v241, s46, v240
    s_lshl_b32 s47, s10, 3
    s_add_u32 s47, s47, s11
    s_lshl_b32 s47, s47, 3
    s_add_u32 s46, s47, s17
    s_lshl_b32 s86, s46, 4
    s_add_u32 s86, s86, s14
    s_lshl_b32 s86, s86, 10
    s_add_u32 s86, s86, 2097152
    s_add_u32 s87, s86, 8192
    s_lshl_b32 s90, s46, 3
    s_add_u32 s90, s90, s14
    s_lshl_b32 s90, s90, 7
    s_add_u32 s90, s90, 1310720
    s_add_u32 s46, s47, s14
    s_lshl_b32 s91, s46, 10
    s_add_u32 s91, s91, 1310720
    s_lshl_b32 s46, s46, 1
    s_and_b32 s9, s17, 1
    s_add_u32 s46, s46, s9
    s_lshl_b32 s46, s46, 13
    s_add_u32 s88, s46, 2097152
    s_add_u32 s89, s88, 4096
    v_min_u32 v247, 7, v0
    v_lshlrev_b32 v247, 7, v247
    s_lshl_b32 s46, s10, 1
    s_and_b32 s47, s14, 1
    s_add_u32 s46, s46, s47
    s_lshl_b32 s92, s46, 15
    s_lshl_b32 s46, s11, 2
    s_lshr_b32 s47, s14, 1
    s_add_u32 s46, s46, s47
    s_lshl_b32 s46, s46, 1
    s_add_u32 s46, s46, s9
    s_lshl_b32 s46, s46, 5
    s_add_u32 s92, s92, s46
    s_bfe_u32 s46, s17, 0x10001
    s_lshl_b32 s46, s46, 5
    v_and_b32 v251, 31, v0
    v_add_u32 v251, s46, v251
    v_lshrrev_b32 v252, 5, v0
    v_lshlrev_b32 v252, 10, v252
    v_lshl_add_u32 v253, v251, 4, v252
    v_and_b32 v248, 15, v0
    v_lshlrev_b32 v248, 11, v248
    v_lshrrev_b32 v251, 4, v251
    v_lshl_add_u32 v248, v251, 3, v248
    s_mul_i32 s46, s14, 917504
    s_lshl_b32 s47, s11, 8
    s_add_u32 s94, s46, s47
    v_mov_b32 v6, 0
    v_mov_b32 v7, 0
    v_and_b32 v251, 1, v0
    v_mul_u32_u24 v251, 14, v251
    v_bfe_u32 v252, v0, 1, 1
    v_add_lshl_u32 v250, v251, v252, 7
    s_lshl_b32 s46, s14, 1
    s_and_b32 s47, s15, 1
    s_add_u32 s46, s46, s47
    s_mul_i32 s46, s46, 14
    s_add_u32 s46, s46, s11
    s_lshl_b32 s46, s46, 8
    s_add_u32 s3, s46, 1048576
    s_setpc_b64 s[6:7]
H_WD:
    s_lshr_b32 s11, s16, 1
    s_and_b32 s10, s16, 1
    s_add_u32 s10, s10, 2
    s_sub_u32 s47, s16, 14
    s_cmp_ge_u32 s16, 14
    s_cselect_b32 s11, 7, s11
    s_cselect_b32 s10, s47, s10
    s_call_b64 s[6:7], P2SETUP
    s_lshl_b32 s47, s17, 13
    s_add_u32 s46, s94, s47
    s_and_b32 s47, s17, 1
    s_lshl_b32 s47, s47, 2
    v_add_u32 v13, s47, v12
    v_lshlrev_b32 v13, 1, v13
    v_and_b32 v14, 15, v0
    v_xor_b32 v13, v13, v14
    v_lshlrev_b32 v13, 4, v13
    v_lshlrev_b32 v14, 11, v12
    v_add3_u32 v2, v13, v14, s46
    s_lshl_b32 s52, s17, 10
    s_and_b32 s51, s10, 1
    s_mul_i32 s51, s51, 7
    s_mov_b32 s50, 0
    s_waitcnt lgkmcnt(0)
    s_barrier
    global_load_dwordx2 v[84:85], v249, s[44:45] sc1
HW_LOOP:
    s_lshl_b32 s47, s51, 13
    s_add_u32 s48, s47, 98304
    s_sub_u32 s47, s47, 65536
    s_cmp_lt_u32 s51, 8
    s_cselect_b32 s47, s48, s47
    s_add_u32 m0, s47, s52
    s_lshl_b32 s48, s51, 16
    buffer_load_dwordx4 v2, s[36:39], s48 offen lds
    s_add_u32 s51, s51, 1
    s_cmp_eq_u32 s51, 14
    s_cselect_b32 s51, 0, s51
    s_add_u32 s50, s50, 1
    s_cmp_lg_u32 s50, 7
    s_cbranch_scc1 HW_NB
    s_barrier
HW_NB:
    s_cmp_lt_u32 s50, 14
    s_cbranch_scc1 HW_LOOP
    s_waitcnt vmcnt(0)
    s_branch P_B1
L_SETUP:
    s_call_b64 s[6:7], P2SETUP
    s_lshl_b32 s47, s16, 14
    s_add_u32 s46, s94, s47
    v_lshlrev_b32 v13, 1, v12
    v_and_b32 v14, 15, v0
    v_xor_b32 v13, v13, v14
    v_lshlrev_b32 v13, 4, v13
    v_lshlrev_b32 v14, 11, v12
    v_add3_u32 v6, v13, v14, s46
    v_xor_b32 v7, 128, v6
    v_add_u32 v7, 7168, v7
    s_add_u32 m0, s51, 8192
    s_add_u32 s50, s50, 1
    buffer_load_dwordx4 v2, s[28:31], s48 offen lds
    buffer_load_dwordx4 v3, s[28:31], s48 offen offset:1024 lds
    s_sub_u32 m0, s51, 8192
    s_and_b32 s52, s50, 3
    buffer_load_dwordx4 v4, s[20:23], s49 offen lds
    buffer_load_dwordx4 v5, s[20:23], s49 offen offset:1024 lds
    s_mul_i32 s52, s52, 24576
    s_add_u32 s51, s52, s53
    s_add_u32 s48, s48, 458752
    s_mov_b32 m0, s51
    s_lshl_b32 s49, s50, 7
    buffer_load_dwordx4 v2, s[24:27], s48 offen lds
    buffer_load_dwordx4 v3, s[24:27], s48 offen offset:1024 lds
L_LOOP:
    s_waitcnt vmcnt(8)
    s_barrier
    s_add_u32 m0, s51, 8192
    s_add_u32 s50, s50, 1
    buffer_load_dwordx4 v2, s[28:31], s48 offen lds
    buffer_load_dwordx4 v3, s[28:31], s48 offen offset:1024 lds
    s_sub_u32 m0, s51, 8192
    s_and_b32 s52, s50, 3
    buffer_load_dwordx4 v4, s[20:23], s49 offen lds
    buffer_load_dwordx4 v5, s[20:23], s49 offen offset:1024 lds
    s_mul_i32 s52, s52, 24576
    s_add_u32 s51, s52, s53
    s_add_u32 s48, s48, 458752
    s_cmp_eq_u32 s50, 16
    s_cbranch_scc1 L_TAIL
    s_mov_b32 m0, s51
    s_lshl_b32 s49, s50, 7
    buffer_load_dwordx4 v2, s[24:27], s48 offen lds
    buffer_load_dwordx4 v3, s[24:27], s48 offen offset:1024 lds
    s_branch L_LOOP
L_TAIL:
    global_load_dwordx2 v[84:85], v249, s[44:45] sc1
    s_lshl_b32 s52, s16, 11
    s_add_u32 m0, s52, 98304
    s_mov_b32 s48, 0
LW_E1:
    buffer_load_dwordx4 v6, s[36:39], s48 offen lds
    buffer_load_dwordx4 v7, s[36:39], s48 offen offset:1024 lds
    s_add_u32 s48, s48, 65536
    s_add_u32 m0, m0, 8192
    s_cmp_eq_u32 s48, 524288
    s_cselect_b32 m0, s52, m0
    s_cmp_lt_u32 s48, 65536
    s_cbranch_scc1 LW_E1
    s_waitcnt vmcnt(9)
    s_barrier
LW_E2:
    buffer_load_dwordx4 v6, s[36:39], s48 offen lds
    buffer_load_dwordx4 v7, s[36:39], s48 offen offset:1024 lds
    s_add_u32 s48, s48, 65536
    s_add_u32 m0, m0, 8192
    s_cmp_eq_u32 s48, 524288
    s_cselect_b32 m0, s52, m0
    s_cmp_lt_u32 s48, 196608
    s_cbranch_scc1 LW_E2
    s_waitcnt vmcnt(7)
    s_barrier
LW_LOOP:
    buffer_load_dwordx4 v6, s[36:39], s48 offen lds
    buffer_load_dwordx4 v7, s[36:39], s48 offen offset:1024 lds
    s_add_u32 s48, s48, 65536
    s_add_u32 m0, m0, 8192
    s_cmp_eq_u32 s48, 524288
    s_cselect_b32 m0, s52, m0
    s_cmp_lt_u32 s48, 720896
    s_cbranch_scc1 LW_LOOP
    s_waitcnt vmcnt(8)
    s_branch P_B1
W_COMPUTE:
    s_call_b64 s[6:7], P2SETUP
    s_or_b32 s46, s2, s17
    s_cmp_lg_u32 s46, 0
    s_cbranch_scc1 W_NT
    s_waitcnt lgkmcnt(0)
    v_mov_b32 v84, s56
    v_mov_b32 v85, s57
    global_store_dwordx2 v249, v[84:85], s[44:45] sc1
W_NT:
    s_and_b32 s18, s17, 1
    s_lshr_b32 s19, s17, 1
    v_and_b32 v13, 31, v0
    v_lshrrev_b32 v14, 5, v0
    v_bfe_u32 v15, v0, 1, 3
    v_xor_b32 v15, v15, v14
    v_lshlrev_b32 v15, 4, v15
    v_lshl_add_u32 v15, v13, 7, v15
    s_lshl_b32 s46, s18, 12
    v_add_u32 v16, s46, v15
    v_xor_b32 v17, 32, v16
    v_xor_b32 v18, 64, v16
    v_xor_b32 v19, 96, v16
    v_add_u32 v20, 49152, v16
    v_add_u32 v21, 49152, v17
    v_add_u32 v22, 49152, v18
    v_add_u32 v23, 49152, v19
    v_bfe_u32 v13, v0, 2, 2
    v_lshl_add_u32 v15, v14, 3, v13
    v_lshlrev_b32 v15, 7, v15
    v_bfe_u32 v13, v0, 3, 1
    v_xor_b32 v13, s19, v13
    v_lshl_add_u32 v15, v13, 6, v15
    v_and_b32 v13, 1, v12
    v_lshl_add_u32 v15, v13, 5, v15
    v_and_b32 v13, 3, v0
    v_lshl_add_u32 v15, v13, 3, v15
    v_add_u32 v24, 8192, v15
    v_add_u32 v25, 57344, v15
    v_mov_b32 v96, 0
    v_mov_b32 v97, 0
    v_mov_b32 v98, 0
    v_mov_b32 v99, 0
    v_mov_b32 v100, 0
    v_mov_b32 v101, 0
    v_mov_b32 v102, 0
    v_mov_b32 v103, 0
    v_mov_b32 v104, 0
    v_mov_b32 v105, 0
    v_mov_b32 v106, 0
    v_mov_b32 v107, 0
    v_mov_b32 v108, 0
    v_mov_b32 v109, 0
    v_mov_b32 v110, 0
    v_mov_b32 v111, 0
    v_mov_b32 v112, 0
    v_mov_b32 v113, 0
    v_mov_b32 v114, 0
    v_mov_b32 v115, 0
    v_mov_b32 v116, 0
    v_mov_b32 v117, 0
    v_mov_b32 v118, 0
    v_mov_b32 v119, 0
    v_mov_b32 v120, 0
    v_mov_b32 v121, 0
    v_mov_b32 v122, 0
    v_mov_b32 v123, 0
    v_mov_b32 v124, 0
    v_mov_b32 v125, 0
    v_mov_b32 v126, 0
    v_mov_b32 v127, 0
    v_mov_b32 v56, 0
    v_mov_b32 v57, 0
    v_mov_b32 v58, 0
    v_mov_b32 v59, 0
    v_mov_b32 v60, 0
    v_mov_b32 v61, 0
    v_mov_b32 v62, 0
    v_mov_b32 v63, 0
    v_mov_b32 v64, 0
    v_mov_b32 v65, 0
    v_mov_b32 v66, 0
    v_mov_b32 v67, 0
    v_mov_b32 v68, 0
    v_mov_b32 v69, 0
    v_mov_b32 v70, 0
    v_mov_b32 v71, 0
    v_mov_b32 v72, 0
    v_mov_b32 v73, 0
    v_mov_b32 v74, 0
    v_mov_b32 v75, 0
    v_mov_b32 v76, 0
    v_mov_b32 v77, 0
    v_mov_b32 v78, 0
    v_mov_b32 v79, 0
    s_lshl_b32 s46, s13, 2
    s_lshl_b32 s47, s18, 1
    s_add_u32 s46, s46, s47
    s_mul_i32 s46, s46, 112
    s_lshl_b32 s47, s12, 1
    s_add_u32 s46, s46, s47
    s_add_u32 s46, s46, s19
    s_lshl_b32 s46, s46, 10
    s_add_u32 s46, s46, 65536
    v_and_b32 v13, 1, v12
    v_mul_u32_u24 v13, 114688, v13
    v_lshl_add_u32 v13, v14, 8, v13
    v_and_b32 v15, 15, v0
    v_lshl_add_u32 v13, v15, 4, v13
    v_add_u32 v26, s46, v13
    v_mov_b32 v30, 0xbfb8aa3b
    v_mov_b32 v31, 0xbfb8aa3b
    v_mov_b32 v80, 1.0
    v_mov_b32 v81, 1.0
    s_lshl_b32 s46, s14, 1
    s_add_u32 s46, s46, s13
    s_lshl_b32 s46, s46, 1
    s_add_u32 s46, s46, s18
    s_mul_i32 s46, s46, 14
    s_lshl_b32 s47, s11, 1
    s_add_u32 s46, s46, s47
    s_add_u32 s46, s46, s19
    s_lshl_b32 s46, s46, 7
    s_add_u32 s93, s46, 1114112
    s_mov_b32 s50, 0
    s_waitcnt lgkmcnt(0)
C_LOOP:
    s_barrier
    v_mfma_f32_32x32x16_bf16 v[96:111], v[60:63], v[56:59], v[96:111]
    ds_read_b128 v[32:35], v16 offset:0
    ds_read_b64_tr_b16 v[36:37], v24 offset:0
    ds_read_b64_tr_b16 v[38:39], v24 offset:512
    v_mfma_f32_32x32x16_bf16 v[112:127], v[64:67], v[56:59], v[112:127]
    ds_read_b64_tr_b16 v[40:41], v24 offset:8192
    ds_read_b64_tr_b16 v[42:43], v24 offset:8704
    ds_read_b128 v[44:47], v17 offset:0
    v_mfma_f32_32x32x16_bf16 v[96:111], v[72:75], v[68:71], v[96:111]
    ds_read_b64_tr_b16 v[48:49], v24 offset:2048
    ds_read_b64_tr_b16 v[50:51], v24 offset:2560
    ds_read_b64_tr_b16 v[52:53], v24 offset:10240
    v_mfma_f32_32x32x16_bf16 v[112:127], v[76:79], v[68:71], v[112:127]
    ds_read_b64_tr_b16 v[54:55], v24 offset:10752
    ds_read_b128 v[56:59], v18 offset:0
    ds_read_b64_tr_b16 v[60:61], v24 offset:4096
    s_waitcnt lgkmcnt(7)
    v_mfma_f32_32x32x16_bf16 v[96:111], v[36:39], v[32:35], v[96:111]
    ds_read_b64_tr_b16 v[62:63], v24 offset:4608
    ds_read_b64_tr_b16 v[64:65], v24 offset:12288
    ds_read_b64_tr_b16 v[66:67], v24 offset:12800
    v_mfma_f32_32x32x16_bf16 v[112:127], v[40:43], v[32:35], v[112:127]
    ds_read_b128 v[68:71], v19 offset:0
    ds_read_b64_tr_b16 v[72:73], v24 offset:6144
    ds_read_b64_tr_b16 v[74:75], v24 offset:6656
    s_waitcnt lgkmcnt(8)
    v_mfma_f32_32x32x16_bf16 v[96:111], v[48:51], v[44:47], v[96:111]
    ds_read_b64_tr_b16 v[76:77], v24 offset:14336
    ds_read_b64_tr_b16 v[78:79], v24 offset:14848
    v_mfma_f32_32x32x16_bf16 v[112:127], v[52:55], v[44:47], v[112:127]
    s_waitcnt lgkmcnt(0)
    s_barrier
    v_mfma_f32_32x32x16_bf16 v[96:111], v[60:63], v[56:59], v[96:111]
    ds_read_b128 v[32:35], v16 offset:24576
    ds_read_b64_tr_b16 v[36:37], v24 offset:24576
    ds_read_b64_tr_b16 v[38:39], v24 offset:25088
    v_mfma_f32_32x32x16_bf16 v[112:127], v[64:67], v[56:59], v[112:127]
    ds_read_b64_tr_b16 v[40:41], v24 offset:32768
    ds_read_b64_tr_b16 v[42:43], v24 offset:33280
    ds_read_b128 v[44:47], v17 offset:24576
    v_mfma_f32_32x32x16_bf16 v[96:111], v[72:75], v[68:71], v[96:111]
    ds_read_b64_tr_b16 v[48:49], v24 offset:26624
    ds_read_b64_tr_b16 v[50:51], v24 offset:27136
    ds_read_b64_tr_b16 v[52:53], v24 offset:34816
    v_mfma_f32_32x32x16_bf16 v[112:127], v[76:79], v[68:71], v[112:127]
    ds_read_b64_tr_b16 v[54:55], v24 offset:35328
    ds_read_b128 v[56:59], v18 offset:24576
    ds_read_b64_tr_b16 v[60:61], v24 offset:28672
    s_waitcnt lgkmcnt(7)
    v_mfma_f32_32x32x16_bf16 v[96:111], v[36:39], v[32:35], v[96:111]
    ds_read_b64_tr_b16 v[62:63], v24 offset:29184
    ds_read_b64_tr_b16 v[64:65], v24 offset:36864
    ds_read_b64_tr_b16 v[66:67], v24 offset:37376
    v_mfma_f32_32x32x16_bf16 v[112:127], v[40:43], v[32:35], v[112:127]
    ds_read_b128 v[68:71], v19 offset:24576
    ds_read_b64_tr_b16 v[72:73], v24 offset:30720
    ds_read_b64_tr_b16 v[74:75], v24 offset:31232
    s_waitcnt lgkmcnt(8)
    v_mfma_f32_32x32x16_bf16 v[96:111], v[48:51], v[44:47], v[96:111]
    ds_read_b64_tr_b16 v[76:77], v24 offset:38912
    ds_read_b64_tr_b16 v[78:79], v24 offset:39424
    v_mfma_f32_32x32x16_bf16 v[112:127], v[52:55], v[44:47], v[112:127]
    s_waitcnt lgkmcnt(0)
    s_barrier
    v_mfma_f32_32x32x16_bf16 v[96:111], v[60:63], v[56:59], v[96:111]
    ds_read_b128 v[32:35], v20 offset:0
    ds_read_b64_tr_b16 v[36:37], v25 offset:0
    ds_read_b64_tr_b16 v[38:39], v25 offset:512
    v_mfma_f32_32x32x16_bf16 v[112:127], v[64:67], v[56:59], v[112:127]
    ds_read_b64_tr_b16 v[40:41], v25 offset:8192
    ds_read_b64_tr_b16 v[42:43], v25 offset:8704
    ds_read_b128 v[44:47], v21 offset:0
    v_mfma_f32_32x32x16_bf16 v[96:111], v[72:75], v[68:71], v[96:111]
    ds_read_b64_tr_b16 v[48:49], v25 offset:2048
    ds_read_b64_tr_b16 v[50:51], v25 offset:2560
    ds_read_b64_tr_b16 v[52:53], v25 offset:10240
    v_mfma_f32_32x32x16_bf16 v[112:127], v[76:79], v[68:71], v[112:127]
    ds_read_b64_tr_b16 v[54:55], v25 offset:10752
    ds_read_b128 v[56:59], v22 offset:0
    ds_read_b64_tr_b16 v[60:61], v25 offset:4096
    s_waitcnt lgkmcnt(7)
    v_mfma_f32_32x32x16_bf16 v[96:111], v[36:39], v[32:35], v[96:111]
    ds_read_b64_tr_b16 v[62:63], v25 offset:4608
    ds_read_b64_tr_b16 v[64:65], v25 offset:12288
    ds_read_b64_tr_b16 v[66:67], v25 offset:12800
    v_mfma_f32_32x32x16_bf16 v[112:127], v[40:43], v[32:35], v[112:127]
    ds_read_b128 v[68:71], v23 offset:0
    ds_read_b64_tr_b16 v[72:73], v25 offset:6144
    ds_read_b64_tr_b16 v[74:75], v25 offset:6656
    s_waitcnt lgkmcnt(8)
    v_mfma_f32_32x32x16_bf16 v[96:111], v[48:51], v[44:47], v[96:111]
    ds_read_b64_tr_b16 v[76:77], v25 offset:14336
    ds_read_b64_tr_b16 v[78:79], v25 offset:14848
    v_mfma_f32_32x32x16_bf16 v[112:127], v[52:55], v[44:47], v[112:127]
    s_waitcnt lgkmcnt(0)
    s_barrier
    v_mfma_f32_32x32x16_bf16 v[96:111], v[60:63], v[56:59], v[96:111]
    ds_read_b128 v[32:35], v20 offset:24576
    ds_read_b64_tr_b16 v[36:37], v25 offset:24576
    ds_read_b64_tr_b16 v[38:39], v25 offset:25088
    v_mfma_f32_32x32x16_bf16 v[112:127], v[64:67], v[56:59], v[112:127]
    ds_read_b64_tr_b16 v[40:41], v25 offset:32768
    ds_read_b64_tr_b16 v[42:43], v25 offset:33280
    ds_read_b128 v[44:47], v21 offset:24576
    v_mfma_f32_32x32x16_bf16 v[96:111], v[72:75], v[68:71], v[96:111]
    ds_read_b64_tr_b16 v[48:49], v25 offset:26624
    ds_read_b64_tr_b16 v[50:51], v25 offset:27136
    ds_read_b64_tr_b16 v[52:53], v25 offset:34816
    v_mfma_f32_32x32x16_bf16 v[112:127], v[76:79], v[68:71], v[112:127]
    ds_read_b64_tr_b16 v[54:55], v25 offset:35328
    ds_read_b128 v[56:59], v22 offset:24576
    ds_read_b64_tr_b16 v[60:61], v25 offset:28672
    s_waitcnt lgkmcnt(7)
    v_mfma_f32_32x32x16_bf16 v[96:111], v[36:39], v[32:35], v[96:111]
    ds_read_b64_tr_b16 v[62:63], v25 offset:29184
    ds_read_b64_tr_b16 v[64:65], v25 offset:36864
    ds_read_b64_tr_b16 v[66:67], v25 offset:37376
    v_mfma_f32_32x32x16_bf16 v[112:127], v[40:43], v[32:35], v[112:127]
    ds_read_b128 v[68:71], v23 offset:24576
    ds_read_b64_tr_b16 v[72:73], v25 offset:30720
    ds_read_b64_tr_b16 v[74:75], v25 offset:31232
    s_waitcnt lgkmcnt(8)
    v_mfma_f32_32x32x16_bf16 v[96:111], v[48:51], v[44:47], v[96:111]
    ds_read_b64_tr_b16 v[76:77], v25 offset:38912
    ds_read_b64_tr_b16 v[78:79], v25 offset:39424
    v_mfma_f32_32x32x16_bf16 v[112:127], v[52:55], v[44:47], v[112:127]
    s_add_u32 s50, s50, 1
    s_cmp_lt_u32 s50, 3
    s_waitcnt lgkmcnt(0)
    s_cbranch_scc1 C_LOOP
    s_barrier
    global_load_dwordx2 v[84:85], v249, s[44:45] sc1
    v_mfma_f32_32x32x16_bf16 v[96:111], v[60:63], v[56:59], v[96:111]
    ds_read_b128 v[32:35], v16 offset:0
    ds_read_b64_tr_b16 v[36:37], v24 offset:0
    ds_read_b64_tr_b16 v[38:39], v24 offset:512
    v_mfma_f32_32x32x16_bf16 v[112:127], v[64:67], v[56:59], v[112:127]
    ds_read_b64_tr_b16 v[40:41], v24 offset:8192
    ds_read_b64_tr_b16 v[42:43], v24 offset:8704
    ds_read_b128 v[44:47], v17 offset:0
    v_mfma_f32_32x32x16_bf16 v[96:111], v[72:75], v[68:71], v[96:111]
    ds_read_b64_tr_b16 v[48:49], v24 offset:2048
    ds_read_b64_tr_b16 v[50:51], v24 offset:2560
    ds_read_b64_tr_b16 v[52:53], v24 offset:10240
    v_mfma_f32_32x32x16_bf16 v[112:127], v[76:79], v[68:71], v[112:127]
    ds_read_b64_tr_b16 v[54:55], v24 offset:10752
    ds_read_b128 v[56:59], v18 offset:0
    ds_read_b64_tr_b16 v[60:61], v24 offset:4096
    s_waitcnt lgkmcnt(7)
    v_mfma_f32_32x32x16_bf16 v[96:111], v[36:39], v[32:35], v[96:111]
    ds_read_b64_tr_b16 v[62:63], v24 offset:4608
    ds_read_b64_tr_b16 v[64:65], v24 offset:12288
    ds_read_b64_tr_b16 v[66:67], v24 offset:12800
    v_mfma_f32_32x32x16_bf16 v[112:127], v[40:43], v[32:35], v[112:127]
    ds_read_b128 v[68:71], v19 offset:0
    ds_read_b64_tr_b16 v[72:73], v24 offset:6144
    ds_read_b64_tr_b16 v[74:75], v24 offset:6656
    s_waitcnt lgkmcnt(8)
    v_mfma_f32_32x32x16_bf16 v[96:111], v[48:51], v[44:47], v[96:111]
    ds_read_b64_tr_b16 v[76:77], v24 offset:14336
    ds_read_b64_tr_b16 v[78:79], v24 offset:14848
    v_mfma_f32_32x32x16_bf16 v[112:127], v[52:55], v[44:47], v[112:127]
    s_waitcnt lgkmcnt(0)
    s_barrier
    v_mfma_f32_32x32x16_bf16 v[96:111], v[60:63], v[56:59], v[96:111]
    ds_read_b128 v[32:35], v16 offset:24576
    ds_read_b64_tr_b16 v[36:37], v24 offset:24576
    ds_read_b64_tr_b16 v[38:39], v24 offset:25088
    v_mfma_f32_32x32x16_bf16 v[112:127], v[64:67], v[56:59], v[112:127]
    ds_read_b64_tr_b16 v[40:41], v24 offset:32768
    ds_read_b64_tr_b16 v[42:43], v24 offset:33280
    ds_read_b128 v[44:47], v17 offset:24576
    v_mfma_f32_32x32x16_bf16 v[96:111], v[72:75], v[68:71], v[96:111]
    ds_read_b64_tr_b16 v[48:49], v24 offset:26624
    ds_read_b64_tr_b16 v[50:51], v24 offset:27136
    ds_read_b64_tr_b16 v[52:53], v24 offset:34816
    v_mfma_f32_32x32x16_bf16 v[112:127], v[76:79], v[68:71], v[112:127]
    ds_read_b64_tr_b16 v[54:55], v24 offset:35328
    ds_read_b128 v[56:59], v18 offset:24576
    ds_read_b64_tr_b16 v[60:61], v24 offset:28672
    s_waitcnt lgkmcnt(7)
    v_mfma_f32_32x32x16_bf16 v[96:111], v[36:39], v[32:35], v[96:111]
    ds_read_b64_tr_b16 v[62:63], v24 offset:29184
    ds_read_b64_tr_b16 v[64:65], v24 offset:36864
    ds_read_b64_tr_b16 v[66:67], v24 offset:37376
    v_mfma_f32_32x32x16_bf16 v[112:127], v[40:43], v[32:35], v[112:127]
    ds_read_b128 v[68:71], v19 offset:24576
    ds_read_b64_tr_b16 v[72:73], v24 offset:30720
    ds_read_b64_tr_b16 v[74:75], v24 offset:31232
    s_waitcnt lgkmcnt(8)
    v_mfma_f32_32x32x16_bf16 v[96:111], v[48:51], v[44:47], v[96:111]
    ds_read_b64_tr_b16 v[76:77], v24 offset:38912
    ds_read_b64_tr_b16 v[78:79], v24 offset:39424
    v_mfma_f32_32x32x16_bf16 v[112:127], v[52:55], v[44:47], v[112:127]
    s_waitcnt lgkmcnt(0)
    s_barrier
    v_mfma_f32_32x32x16_bf16 v[96:111], v[60:63], v[56:59], v[96:111]
    ds_read_b128 v[32:35], v20 offset:0
    ds_read_b64_tr_b16 v[36:37], v25 offset:0
    ds_read_b64_tr_b16 v[38:39], v25 offset:512
    v_mfma_f32_32x32x16_bf16 v[112:127], v[64:67], v[56:59], v[112:127]
    ds_read_b64_tr_b16 v[40:41], v25 offset:8192
    ds_read_b64_tr_b16 v[42:43], v25 offset:8704
    ds_read_b128 v[44:47], v21 offset:0
    v_mfma_f32_32x32x16_bf16 v[96:111], v[72:75], v[68:71], v[96:111]
    ds_read_b64_tr_b16 v[48:49], v25 offset:2048
    ds_read_b64_tr_b16 v[50:51], v25 offset:2560
    ds_read_b64_tr_b16 v[52:53], v25 offset:10240
    v_mfma_f32_32x32x16_bf16 v[112:127], v[76:79], v[68:71], v[112:127]
    ds_read_b64_tr_b16 v[54:55], v25 offset:10752
    ds_read_b128 v[56:59], v22 offset:0
    ds_read_b64_tr_b16 v[60:61], v25 offset:4096
    s_waitcnt lgkmcnt(7)
    v_mfma_f32_32x32x16_bf16 v[96:111], v[36:39], v[32:35], v[96:111]
    ds_read_b64_tr_b16 v[62:63], v25 offset:4608
    ds_read_b64_tr_b16 v[64:65], v25 offset:12288
    ds_read_b64_tr_b16 v[66:67], v25 offset:12800
    v_mfma_f32_32x32x16_bf16 v[112:127], v[40:43], v[32:35], v[112:127]
    ds_read_b128 v[68:71], v23 offset:0
    ds_read_b64_tr_b16 v[72:73], v25 offset:6144
    ds_read_b64_tr_b16 v[74:75], v25 offset:6656
    s_waitcnt lgkmcnt(8)
    v_mfma_f32_32x32x16_bf16 v[96:111], v[48:51], v[44:47], v[96:111]
    ds_read_b64_tr_b16 v[76:77], v25 offset:14336
    ds_read_b64_tr_b16 v[78:79], v25 offset:14848
    v_mfma_f32_32x32x16_bf16 v[112:127], v[52:55], v[44:47], v[112:127]
    s_waitcnt lgkmcnt(0)
    v_mfma_f32_32x32x16_bf16 v[96:111], v[60:63], v[56:59], v[96:111]
    v_mfma_f32_32x32x16_bf16 v[112:127], v[64:67], v[56:59], v[112:127]
    v_mfma_f32_32x32x16_bf16 v[96:111], v[72:75], v[68:71], v[96:111]
    v_mfma_f32_32x32x16_bf16 v[112:127], v[76:79], v[68:71], v[112:127]
    s_barrier
    ds_read_b128 v[32:35], v20 offset:24576
    ds_read_b64_tr_b16 v[36:37], v25 offset:24576
    ds_read_b64_tr_b16 v[38:39], v25 offset:25088
    ds_read_b128 v[44:47], v21 offset:24576
    ds_read_b64_tr_b16 v[48:49], v25 offset:26624
    ds_read_b64_tr_b16 v[50:51], v25 offset:27136
    ds_read_b128 v[56:59], v22 offset:24576
    ds_read_b64_tr_b16 v[60:61], v25 offset:28672
    ds_read_b64_tr_b16 v[62:63], v25 offset:29184
    ds_read_b128 v[68:71], v23 offset:24576
    ds_read_b64_tr_b16 v[72:73], v25 offset:30720
    ds_read_b64_tr_b16 v[74:75], v25 offset:31232
    ds_read_b64_tr_b16 v[40:41], v25 offset:32768
    ds_read_b64_tr_b16 v[42:43], v25 offset:33280
    ds_read_b64_tr_b16 v[52:53], v25 offset:34816
    s_waitcnt lgkmcnt(12)
    v_mfma_f32_32x32x16_bf16 v[96:111], v[36:39], v[32:35], v[96:111]
    ds_read_b64_tr_b16 v[54:55], v25 offset:35328
    ds_read_b64_tr_b16 v[64:65], v25 offset:36864
    ds_read_b64_tr_b16 v[66:67], v25 offset:37376
    s_waitcnt lgkmcnt(12)
    v_mfma_f32_32x32x16_bf16 v[96:111], v[48:51], v[44:47], v[96:111]
    ds_read_b64_tr_b16 v[76:77], v25 offset:38912
    ds_read_b64_tr_b16 v[78:79], v25 offset:39424
    s_waitcnt lgkmcnt(11)
    v_mfma_f32_32x32x16_bf16 v[96:111], v[60:63], v[56:59], v[96:111]
    s_waitcnt lgkmcnt(8)
    v_mfma_f32_32x32x16_bf16 v[96:111], v[72:75], v[68:71], v[96:111]
    s_waitcnt lgkmcnt(6)
    v_mfma_f32_32x32x16_bf16 v[112:127], v[40:43], v[32:35], v[112:127]
    s_waitcnt lgkmcnt(4)
    v_mfma_f32_32x32x16_bf16 v[112:127], v[52:55], v[44:47], v[112:127]
    s_waitcnt lgkmcnt(0)
    v_mfma_f32_32x32x16_bf16 v[112:127], v[64:67], v[56:59], v[112:127]
    s_nop 5
    v_pk_mul_f32 v[200:201], v[30:31], v[96:97]
    v_pk_mul_f32 v[202:203], v[30:31], v[98:99]
    v_pk_mul_f32 v[204:205], v[30:31], v[100:101]
    v_pk_mul_f32 v[206:207], v[30:31], v[102:103]
    v_mfma_f32_32x32x16_bf16 v[112:127], v[76:79], v[68:71], v[112:127]
    v_pk_mul_f32 v[208:209], v[30:31], v[104:105]
    v_pk_mul_f32 v[210:211], v[30:31], v[106:107]
    v_pk_mul_f32 v[212:213], v[30:31], v[108:109]
    v_pk_mul_f32 v[214:215], v[30:31], v[110:111]
    v_exp_f32 v200, v200
    v_exp_f32 v201, v201
    v_exp_f32 v202, v202
    v_exp_f32 v203, v203
    v_exp_f32 v204, v204
    v_exp_f32 v205, v205
    v_exp_f32 v206, v206
    v_exp_f32 v207, v207
    s_nop 0
    v_pk_add_f32 v[200:201], v[80:81], v[200:201]
    v_pk_add_f32 v[202:203], v[80:81], v[202:203]
    v_pk_add_f32 v[204:205], v[80:81], v[204:205]
    v_pk_add_f32 v[206:207], v[80:81], v[206:207]
    v_rcp_f32 v200, v200
    v_rcp_f32 v201, v201
    v_rcp_f32 v202, v202
    v_rcp_f32 v203, v203
    v_rcp_f32 v204, v204
    v_rcp_f32 v205, v205
    v_rcp_f32 v206, v206
    v_rcp_f32 v207, v207
    v_pk_mul_f32 v[96:97], v[96:97], v[112:113]
    v_pk_mul_f32 v[98:99], v[98:99], v[114:115]
    v_pk_mul_f32 v[100:101], v[100:101], v[116:117]
    v_pk_mul_f32 v[102:103], v[102:103], v[118:119]
    v_pk_mul_f32 v[96:97], v[96:97], v[200:201]
    v_pk_mul_f32 v[98:99], v[98:99], v[202:203]
    v_pk_mul_f32 v[100:101], v[100:101], v[204:205]
    v_pk_mul_f32 v[102:103], v[102:103], v[206:207]
    v_cvt_pk_bf16_f32 v88, v96, v97
    v_cvt_pk_bf16_f32 v89, v98, v99
    v_cvt_pk_bf16_f32 v90, v100, v101
    v_cvt_pk_bf16_f32 v91, v102, v103
    buffer_store_dwordx4 v[88:91], v26, s[32:35], 0 offen offset:0 sc1
    v_exp_f32 v208, v208
    v_exp_f32 v209, v209
    v_exp_f32 v210, v210
    v_exp_f32 v211, v211
    v_exp_f32 v212, v212
    v_exp_f32 v213, v213
    v_exp_f32 v214, v214
    v_exp_f32 v215, v215
    s_nop 0
    v_pk_add_f32 v[208:209], v[80:81], v[208:209]
    v_pk_add_f32 v[210:211], v[80:81], v[210:211]
    v_pk_add_f32 v[212:213], v[80:81], v[212:213]
    v_pk_add_f32 v[214:215], v[80:81], v[214:215]
    v_rcp_f32 v208, v208
    v_rcp_f32 v209, v209
    v_rcp_f32 v210, v210
    v_rcp_f32 v211, v211
    v_rcp_f32 v212, v212
    v_rcp_f32 v213, v213
    v_rcp_f32 v214, v214
    v_rcp_f32 v215, v215
    v_pk_mul_f32 v[104:105], v[104:105], v[120:121]
    v_pk_mul_f32 v[106:107], v[106:107], v[122:123]
    v_pk_mul_f32 v[108:109], v[108:109], v[124:125]
    v_pk_mul_f32 v[110:111], v[110:111], v[126:127]
    v_pk_mul_f32 v[104:105], v[104:105], v[208:209]
    v_pk_mul_f32 v[106:107], v[106:107], v[210:211]
    v_pk_mul_f32 v[108:109], v[108:109], v[212:213]
    v_pk_mul_f32 v[110:111], v[110:111], v[214:215]
    v_cvt_pk_bf16_f32 v92, v104, v105
    v_cvt_pk_bf16_f32 v93, v106, v107
    v_cvt_pk_bf16_f32 v94, v108, v109
    v_cvt_pk_bf16_f32 v95, v110, v111
    buffer_store_dwordx4 v[92:95], v26, s[32:35], 0 offen offset:512 sc1
    s_barrier
    ds_read_b64_tr_b16 v[128:129], v242 offset:0
    ds_read_b64_tr_b16 v[130:131], v242 offset:2048
    ds_read_b64_tr_b16 v[132:133], v243 offset:0
    ds_read_b64_tr_b16 v[134:135], v243 offset:2048
    ds_read_b64_tr_b16 v[136:137], v242 offset:8192
    ds_read_b64_tr_b16 v[138:139], v242 offset:10240
    ds_read_b64_tr_b16 v[140:141], v243 offset:8192
    ds_read_b64_tr_b16 v[142:143], v243 offset:10240
    ds_read_b64_tr_b16 v[144:145], v242 offset:16384
    ds_read_b64_tr_b16 v[146:147], v242 offset:18432
    ds_read_b64_tr_b16 v[148:149], v243 offset:16384
    ds_read_b64_tr_b16 v[150:151], v243 offset:18432
    s_waitcnt lgkmcnt(8)
    ds_read_b64_tr_b16 v[152:153], v242 offset:24576
    ds_read_b64_tr_b16 v[154:155], v242 offset:26624
    ds_read_b64_tr_b16 v[156:157], v243 offset:24576
    ds_read_b64_tr_b16 v[158:159], v243 offset:26624
    s_waitcnt lgkmcnt(8)
    ds_read_b64_tr_b16 v[160:161], v242 offset:32768
    ds_read_b64_tr_b16 v[162:163], v242 offset:34816
    ds_read_b64_tr_b16 v[164:165], v243 offset:32768
    ds_read_b64_tr_b16 v[166:167], v243 offset:34816
    s_waitcnt lgkmcnt(8)
    ds_read_b64_tr_b16 v[168:169], v242 offset:40960
    ds_read_b64_tr_b16 v[170:171], v242 offset:43008
    ds_read_b64_tr_b16 v[172:173], v243 offset:40960
    ds_read_b64_tr_b16 v[174:175], v243 offset:43008
    s_waitcnt lgkmcnt(8)
    ds_read_b64_tr_b16 v[176:177], v242 offset:49152
    ds_read_b64_tr_b16 v[178:179], v242 offset:51200
    ds_read_b64_tr_b16 v[180:181], v243 offset:49152
    ds_read_b64_tr_b16 v[182:183], v243 offset:51200
W_TAG:
    s_waitcnt vmcnt(0)
    v_cmp_ne_u64 vcc, 0, v[84:85]
    s_cbranch_vccnz W_FLAG
    s_add_u32 s8, s8, 1
    s_cmp_gt_u32 s8, 200000
    s_cbranch_scc1 DONE2
    global_load_dwordx2 v[84:85], v249, s[44:45] sc1
    s_branch W_TAG
W_FLAG:
    buffer_store_dwordx2 v[84:85], v249, s[32:35], s93 offen
    s_mov_b32 s9, 0
    buffer_load_dwordx2 v[86:87], v246, s[32:35], s80 offen sc1
    s_branch P_B2
P_B1:
    v_cmp_ne_u64 vcc, 0, v[84:85]
    s_cbranch_vccnz P_TAGOK
    s_add_u32 s8, s8, 1
    s_cmp_gt_u32 s8, 200000
    s_cbranch_scc1 DONE2
    global_load_dwordx2 v[84:85], v249, s[44:45] sc1
    s_waitcnt vmcnt(0)
    s_branch P_B1
P_TAGOK:
    s_barrier
    s_cmp_ge_u32 s15, 14
    s_cbranch_scc1 P_NL
LW_LOOP2:
    buffer_load_dwordx4 v6, s[36:39], s48 offen lds
    buffer_load_dwordx4 v7, s[36:39], s48 offen offset:1024 lds
    s_add_u32 s48, s48, 65536
    s_add_u32 m0, m0, 8192
    s_cmp_eq_u32 s48, 524288
    s_cselect_b32 m0, s52, m0
    s_cmp_lt_u32 s48, 917504
    s_cbranch_scc1 LW_LOOP2
P_NL:
    ds_read_b64_tr_b16 v[128:129], v242 offset:0
    ds_read_b64_tr_b16 v[130:131], v242 offset:2048
    ds_read_b64_tr_b16 v[132:133], v243 offset:0
    ds_read_b64_tr_b16 v[134:135], v243 offset:2048
    ds_read_b64_tr_b16 v[136:137], v242 offset:8192
    ds_read_b64_tr_b16 v[138:139], v242 offset:10240
    ds_read_b64_tr_b16 v[140:141], v243 offset:8192
    ds_read_b64_tr_b16 v[142:143], v243 offset:10240
    ds_read_b64_tr_b16 v[144:145], v242 offset:16384
    ds_read_b64_tr_b16 v[146:147], v242 offset:18432
    ds_read_b64_tr_b16 v[148:149], v243 offset:16384
    ds_read_b64_tr_b16 v[150:151], v243 offset:18432
    s_waitcnt lgkmcnt(8)
    ds_read_b64_tr_b16 v[152:153], v242 offset:24576
    ds_read_b64_tr_b16 v[154:155], v242 offset:26624
    ds_read_b64_tr_b16 v[156:157], v243 offset:24576
    ds_read_b64_tr_b16 v[158:159], v243 offset:26624
    s_waitcnt lgkmcnt(8)
    ds_read_b64_tr_b16 v[160:161], v242 offset:32768
    ds_read_b64_tr_b16 v[162:163], v242 offset:34816
    ds_read_b64_tr_b16 v[164:165], v243 offset:32768
    ds_read_b64_tr_b16 v[166:167], v243 offset:34816
    s_waitcnt lgkmcnt(8)
    ds_read_b64_tr_b16 v[168:169], v242 offset:40960
    ds_read_b64_tr_b16 v[170:171], v242 offset:43008
    ds_read_b64_tr_b16 v[172:173], v243 offset:40960
    ds_read_b64_tr_b16 v[174:175], v243 offset:43008
    s_waitcnt lgkmcnt(8)
    ds_read_b64_tr_b16 v[176:177], v242 offset:49152
    ds_read_b64_tr_b16 v[178:179], v242 offset:51200
    ds_read_b64_tr_b16 v[180:181], v243 offset:49152
    ds_read_b64_tr_b16 v[182:183], v243 offset:51200
    s_cmp_ge_u32 s17, 4
    s_cselect_b32 s9, 1, 0
    s_cbranch_scc0 P_NW
    s_waitcnt vmcnt(0)
    s_branch P_B2
P_NW:
    buffer_load_dwordx2 v[86:87], v246, s[32:35], s80 offen sc1
P_B2:
    s_barrier
    v_and_b32 v92, s95, v84
    v_bfe_u32 v93, v84, 12, 12
    v_alignbit_b32 v94, v85, v84, 24
    v_and_b32 v94, s95, v94
    v_bfe_u32 v95, v85, 4, 12
    v_xor_b32 v93, v93, v92
    v_xor_b32 v94, v94, v92
    v_xor_b32 v95, v95, v92
    s_cmp_eq_u32 s9, 1
    s_cbranch_scc1 P_RD
    s_branch P_CHK
P_SLEEP:
    s_sleep 1
    s_add_u32 s54, s54, 1
    s_cmp_lg_u32 s54, 8
    s_cbranch_scc1 P_TW
    v_mov_b32 v246, v254
    s_cmp_ge_u32 s15, 14
    s_cbranch_scc1 P_TW
    buffer_store_dwordx2 v[84:85], v250, s[32:35], s3 offen sc1
P_TW:
    buffer_load_dwordx2 v[86:87], v246, s[32:35], s80 offen sc1
    s_add_u32 s8, s8, 1
    s_cmp_gt_u32 s8, 200000
    s_cbranch_scc1 DONE2
P_CHK:
    s_waitcnt vmcnt(0)
    v_cmp_eq_u64 vcc, v[84:85], v[86:87]
    s_lshr_b32 s46, vcc_lo, 4
    s_or_b32 s46, s46, vcc_lo
    s_and_b32 s46, s46, 15
    s_cmp_eq_u32 s46, 15
    s_cbranch_scc0 P_SLEEP
    s_mov_b32 m0, s85
    s_mov_b32 s9, 1
    buffer_load_dwordx4 v240, s[32:35], s81 offen sc1 lds
    buffer_load_dwordx4 v240, s[32:35], s82 offen offset:1024 sc1 lds
    buffer_load_dwordx4 v240, s[32:35], s83 offen offset:2048 sc1 lds
    buffer_load_dwordx4 v240, s[32:35], s84 offen offset:3072 sc1 lds
    s_cmp_eq_u32 s17, 3
    s_cbranch_scc1 P_H3
    s_add_u32 m0, s85, 4096
    v_add_u32 v251, 2048, v240
    buffer_load_dwordx4 v251, s[32:35], s81 offen sc1 lds
    buffer_load_dwordx4 v251, s[32:35], s82 offen offset:1024 sc1 lds
    buffer_load_dwordx4 v251, s[32:35], s83 offen offset:2048 sc1 lds
    buffer_load_dwordx4 v251, s[32:35], s84 offen offset:3072 sc1 lds
P_H3:
P_RD:
    s_waitcnt lgkmcnt(8)
    ds_read_b64_tr_b16 v[184:185], v242 offset:57344
    ds_read_b64_tr_b16 v[186:187], v242 offset:59392
    ds_read_b64_tr_b16 v[188:189], v243 offset:57344
    ds_read_b64_tr_b16 v[190:191], v243 offset:59392
    s_waitcnt lgkmcnt(8)
    ds_read_b64_tr_b16 v[192:193], v244 offset:0
    ds_read_b64_tr_b16 v[194:195], v244 offset:2048
    ds_read_b64_tr_b16 v[196:197], v245 offset:0
    ds_read_b64_tr_b16 v[198:199], v245 offset:2048
    s_waitcnt lgkmcnt(8)
    ds_read_b64_tr_b16 v[200:201], v244 offset:8192
    ds_read_b64_tr_b16 v[202:203], v244 offset:10240
    ds_read_b64_tr_b16 v[204:205], v245 offset:8192
    ds_read_b64_tr_b16 v[206:207], v245 offset:10240
    s_waitcnt lgkmcnt(8)
    ds_read_b64_tr_b16 v[208:209], v244 offset:16384
    ds_read_b64_tr_b16 v[210:211], v244 offset:18432
    ds_read_b64_tr_b16 v[212:213], v245 offset:16384
    ds_read_b64_tr_b16 v[214:215], v245 offset:18432
    s_waitcnt lgkmcnt(8)
    ds_read_b64_tr_b16 v[216:217], v244 offset:24576
    ds_read_b64_tr_b16 v[218:219], v244 offset:26624
    ds_read_b64_tr_b16 v[220:221], v245 offset:24576
    ds_read_b64_tr_b16 v[222:223], v245 offset:26624
    s_waitcnt lgkmcnt(8)
    ds_read_b64_tr_b16 v[224:225], v244 offset:32768
    ds_read_b64_tr_b16 v[226:227], v244 offset:34816
    ds_read_b64_tr_b16 v[228:229], v245 offset:32768
    ds_read_b64_tr_b16 v[230:231], v245 offset:34816
    s_waitcnt lgkmcnt(8)
    ds_read_b64_tr_b16 v[232:233], v244 offset:40960
    ds_read_b64_tr_b16 v[234:235], v244 offset:43008
    ds_read_b64_tr_b16 v[236:237], v245 offset:40960
    ds_read_b64_tr_b16 v[238:239], v245 offset:43008
    v_mov_b32 v8, 0
    v_mov_b32 v9, 0
    v_mov_b32 v10, 0
    v_mov_b32 v11, 0
    v_mov_b32 v12, 0
    v_mov_b32 v13, 0
    v_mov_b32 v14, 0
    v_mov_b32 v15, 0
    s_cmp_lt_u32 s17, 4
    s_cbranch_scc1 P_WH
    s_setprio 1
    s_branch P_Y
P_WH:
    s_waitcnt vmcnt(0)
P_Y:
    s_waitcnt lgkmcnt(0)
    s_barrier
    ds_read_b128 v[16:19], v241 offset:0
    ds_read_b128 v[20:23], v241 offset:2048
    ds_read_b128 v[24:27], v241 offset:4096
    ds_read_b128 v[28:31], v241 offset:6144
    ds_read_b128 v[32:35], v241 offset:8192
    ds_read_b128 v[36:39], v241 offset:10240
    ds_read_b128 v[40:43], v241 offset:12288
    ds_read_b128 v[44:47], v241 offset:14336
    ds_read_b128 v[48:51], v241 offset:16384
    ds_read_b128 v[52:55], v241 offset:18432
    ds_read_b128 v[56:59], v241 offset:20480
    ds_read_b128 v[60:63], v241 offset:22528
    ds_read_b128 v[64:67], v241 offset:24576
    ds_read_b128 v[68:71], v241 offset:26624
    s_waitcnt lgkmcnt(13)
    v_mfma_f32_16x16x32_bf16 v[8:11], v[128:131], v[16:19], v[8:11]
    v_mfma_f32_16x16x32_bf16 v[12:15], v[132:135], v[16:19], v[12:15]
    s_cmp_ge_u32 s17, 4
    s_cbranch_scc1 P_NN1
    buffer_store_dwordx2 v[84:85], v249, s[32:35], s90 offen sc1
P_NN1:
    s_waitcnt lgkmcnt(12)
    v_mfma_f32_16x16x32_bf16 v[8:11], v[136:139], v[20:23], v[8:11]
    v_mfma_f32_16x16x32_bf16 v[12:15], v[140:143], v[20:23], v[12:15]
    s_waitcnt lgkmcnt(11)
    v_mfma_f32_16x16x32_bf16 v[8:11], v[144:147], v[24:27], v[8:11]
    v_mfma_f32_16x16x32_bf16 v[12:15], v[148:151], v[24:27], v[12:15]
    s_waitcnt lgkmcnt(10)
    v_mfma_f32_16x16x32_bf16 v[8:11], v[152:155], v[28:31], v[8:11]
    v_mfma_f32_16x16x32_bf16 v[12:15], v[156:159], v[28:31], v[12:15]
    s_waitcnt lgkmcnt(9)
    v_mfma_f32_16x16x32_bf16 v[8:11], v[160:163], v[32:35], v[8:11]
    v_mfma_f32_16x16x32_bf16 v[12:15], v[164:167], v[32:35], v[12:15]
    s_waitcnt lgkmcnt(8)
    v_mfma_f32_16x16x32_bf16 v[8:11], v[168:171], v[36:39], v[8:11]
    v_mfma_f32_16x16x32_bf16 v[12:15], v[172:175], v[36:39], v[12:15]
    s_waitcnt lgkmcnt(7)
    v_mfma_f32_16x16x32_bf16 v[8:11], v[176:179], v[40:43], v[8:11]
    v_mfma_f32_16x16x32_bf16 v[12:15], v[180:183], v[40:43], v[12:15]
    s_cmp_lt_u32 s17, 4
    s_cbranch_scc1 P_NN7
    buffer_store_dwordx2 v[84:85], v249, s[32:35], s90 offen sc1
P_NN7:
    s_waitcnt lgkmcnt(6)
    v_mfma_f32_16x16x32_bf16 v[8:11], v[184:187], v[44:47], v[8:11]
    v_mfma_f32_16x16x32_bf16 v[12:15], v[188:191], v[44:47], v[12:15]
    s_waitcnt lgkmcnt(5)
    v_mfma_f32_16x16x32_bf16 v[8:11], v[192:195], v[48:51], v[8:11]
    v_mfma_f32_16x16x32_bf16 v[12:15], v[196:199], v[48:51], v[12:15]
    s_waitcnt lgkmcnt(4)
    v_mfma_f32_16x16x32_bf16 v[8:11], v[200:203], v[52:55], v[8:11]
    v_mfma_f32_16x16x32_bf16 v[12:15], v[204:207], v[52:55], v[12:15]
    s_waitcnt lgkmcnt(3)
    v_mfma_f32_16x16x32_bf16 v[8:11], v[208:211], v[56:59], v[8:11]
    v_mfma_f32_16x16x32_bf16 v[12:15], v[212:215], v[56:59], v[12:15]
    s_waitcnt lgkmcnt(2)
    v_mfma_f32_16x16x32_bf16 v[8:11], v[216:219], v[60:63], v[8:11]
    v_mfma_f32_16x16x32_bf16 v[12:15], v[220:223], v[60:63], v[12:15]
    s_waitcnt lgkmcnt(1)
    v_mfma_f32_16x16x32_bf16 v[8:11], v[224:227], v[64:67], v[8:11]
    v_mfma_f32_16x16x32_bf16 v[12:15], v[228:231], v[64:67], v[12:15]
    s_waitcnt lgkmcnt(0)
    v_mfma_f32_16x16x32_bf16 v[8:11], v[232:235], v[68:71], v[8:11]
    v_mfma_f32_16x16x32_bf16 v[12:15], v[236:239], v[68:71], v[12:15]
    s_nop 6
    v_add_u32 v8, 0x800, v8
    v_add_u32 v9, 0x800, v9
    v_add_u32 v10, 0x800, v10
    v_add_u32 v11, 0x800, v11
    v_bfi_b32 v8, s95, v92, v8
    v_bfi_b32 v9, s95, v93, v9
    v_bfi_b32 v10, s95, v94, v10
    v_bfi_b32 v11, s95, v95, v11
    buffer_store_dwordx4 v[8:11], v240, s[32:35], s86 offen sc1
    v_add_u32 v12, 0x800, v12
    v_add_u32 v13, 0x800, v13
    v_add_u32 v14, 0x800, v14
    v_add_u32 v15, 0x800, v15
    v_bfi_b32 v12, s95, v92, v12
    v_bfi_b32 v13, s95, v93, v13
    v_bfi_b32 v14, s95, v94, v14
    v_bfi_b32 v15, s95, v95, v15
    buffer_store_dwordx4 v[12:15], v240, s[32:35], s87 offen sc1
    s_cmp_lg_u32 s17, 3
    s_cbranch_scc1 P_N7
    s_cmp_ge_u32 s15, 14
    s_cbranch_scc1 P_N7
    buffer_store_dwordx2 v[84:85], v250, s[32:35], s3 offen sc1
P_N7:
    s_cmp_ge_u32 s17, 4
    s_cbranch_scc1 G_START
    s_barrier
    s_endpgm
G_START:
    s_cmp_lg_u32 s17, 4
    s_cbranch_scc1 G_GO
    v_readfirstlane_b32 s55, v84
    s_add_u32 s52, s32, s91
    s_addc_u32 s53, s33, 0
G_NS:
    s_load_dword s80, s[52:53], 0 glc
    s_load_dword s81, s[52:53], 128 glc
    s_load_dword s82, s[52:53], 256 glc
    s_load_dword s83, s[52:53], 384 glc
    s_load_dword s84, s[52:53], 512 glc
    s_load_dword s85, s[52:53], 640 glc
    s_load_dword s46, s[52:53], 768 glc
    s_load_dword s47, s[52:53], 896 glc
    s_add_u32 s8, s8, 1
    s_cmp_gt_u32 s8, 200000
    s_cbranch_scc1 DONE2
    s_waitcnt lgkmcnt(0)
    s_xor_b32 s9, s80, s55
    s_xor_b32 s81, s81, s55
    s_or_b32 s9, s9, s81
    s_xor_b32 s82, s82, s55
    s_or_b32 s9, s9, s82
    s_xor_b32 s83, s83, s55
    s_or_b32 s9, s9, s83
    s_xor_b32 s84, s84, s55
    s_or_b32 s9, s9, s84
    s_xor_b32 s85, s85, s55
    s_or_b32 s9, s9, s85
    s_xor_b32 s46, s46, s55
    s_or_b32 s9, s9, s46
    s_xor_b32 s47, s47, s55
    s_or_b32 s9, s9, s47
    s_cbranch_scc1 G_NS
G_GO:
    s_barrier
G_POLL:
    buffer_load_dwordx4 v[16:19], v253, s[32:35], s88 offen offset:0 sc1
    buffer_load_dwordx4 v[20:23], v253, s[32:35], s88 offen offset:2048 sc1
    buffer_load_dwordx4 v[24:27], v253, s[32:35], s89 offen offset:0 sc1
    buffer_load_dwordx4 v[28:31], v253, s[32:35], s89 offen offset:2048 sc1
    s_add_u32 s8, s8, 1
    s_cmp_gt_u32 s8, 200000
    s_cbranch_scc1 DONE2
    s_waitcnt vmcnt(3)
    v_xor_b32 v16, v92, v16
    v_xor_b32 v17, v93, v17
    v_xor_b32 v18, v94, v18
    v_xor_b32 v19, v95, v19
    v_or3_b32 v76, v16, v17, v18
    v_or_b32 v76, v76, v19
    s_waitcnt vmcnt(2)
    v_xor_b32 v20, v92, v20
    v_xor_b32 v21, v93, v21
    v_xor_b32 v22, v94, v22
    v_xor_b32 v23, v95, v23
    v_or3_b32 v76, v76, v20, v21
    v_or3_b32 v76, v76, v22, v23
    v_pk_add_f32 v[16:17], v[16:17], v[20:21]
    v_pk_add_f32 v[18:19], v[18:19], v[22:23]
    s_waitcnt vmcnt(1)
    v_xor_b32 v24, v92, v24
    v_xor_b32 v25, v93, v25
    v_xor_b32 v26, v94, v26
    v_xor_b32 v27, v95, v27
    v_or3_b32 v76, v76, v24, v25
    v_or3_b32 v76, v76, v26, v27
    v_pk_add_f32 v[16:17], v[16:17], v[24:25]
    v_pk_add_f32 v[18:19], v[18:19], v[26:27]
    s_waitcnt vmcnt(0)
    v_xor_b32 v28, v92, v28
    v_xor_b32 v29, v93, v29
    v_xor_b32 v30, v94, v30
    v_xor_b32 v31, v95, v31
    v_or3_b32 v76, v76, v28, v29
    v_or3_b32 v76, v76, v30, v31
    v_pk_add_f32 v[16:17], v[16:17], v[28:29]
    v_pk_add_f32 v[18:19], v[18:19], v[30:31]
    v_mov_b32 v20, v16
    v_mov_b32 v21, v17
    v_mov_b32 v22, v18
    v_mov_b32 v23, v19
    v_and_b32 v76, s95, v76
    v_cmp_ne_u32 vcc, 0, v76
    v_permlane32_swap_b32 v16, v20
    v_permlane32_swap_b32 v17, v21
    v_permlane32_swap_b32 v18, v22
    v_permlane32_swap_b32 v19, v23
    s_cbranch_vccnz G_POLL
    v_pk_add_f32 v[16:17], v[16:17], v[20:21]
    v_pk_add_f32 v[18:19], v[18:19], v[22:23]
    s_mov_b32 exec_hi, 0
    v_cvt_pk_bf16_f32 v48, v16, v17
    v_cvt_pk_bf16_f32 v49, v18, v19
    buffer_store_dwordx2 v[48:49], v248, s[40:43], s92 offen
DONE2:
    s_endpgm
CODE_END:
.section .rodata,"a"
.p2align 6
.amdhsa_kernel standalone__swiglu_ffn__sampling_kernel
  .amdhsa_next_free_vgpr 256
  .amdhsa_next_free_sgpr 96
  .amdhsa_accum_offset 256
  .amdhsa_group_segment_fixed_size 0
  .amdhsa_kernarg_size 56
  .amdhsa_user_sgpr_count 2
  .amdhsa_user_sgpr_kernarg_segment_ptr 1
  .amdhsa_system_sgpr_workgroup_id_x 1
  .amdhsa_float_denorm_mode_32 3
.end_amdhsa_kernel
```
